```python
import torch

def _softmax(x, axis=-1):
    return torch.softmax(x, dim=axis)
def _gelu(x):
    return torch.nn.functional.gelu(x, approximate="tanh")
def _silu(x):
    return torch.nn.functional.silu(x)
def _sigmoid(x):
    return torch.sigmoid(x)
def _layernorm(x, axis=-1, eps=1e-5):
    m = x.mean(dim=axis, keepdim=True)
    v = x.var(dim=axis, keepdim=True, unbiased=False)
    return (x - m) / torch.sqrt(v + eps)
def _scatter_add(tgt, idx, src, axis=0):
    return tgt.clone().index_add_(axis, idx, src)
def _segment_sum(src, seg, n):
    out = torch.zeros((n,) + src.shape[1:], dtype=src.dtype)
    return out.index_add_(0, seg, src)
def _pad(x, pw):
    flat = tuple(v for pair in reversed(pw) for v in pair)
    return torch.nn.functional.pad(x, flat)

kernel_name = 'standalone__fused_io_aware_attn__prompt'

def setup_inputs():

    _w = (lambda a: (lambda t: t.to(torch.bfloat16) if t.is_floating_point() else t)(torch.as_tensor(a)))
    B, H, S = 1, 32, 2048
    Dh = max(1, 512 // 32)
    return {
        "q": _w((lambda *s: torch.randn(*s, dtype=torch.bfloat16) * 0.8)(B, H, S, Dh)),
        "k": _w((lambda *s: torch.randn(*s, dtype=torch.bfloat16) * 0.8)(B, H, S, Dh)),
        "v": _w((lambda *s: torch.randn(*s, dtype=torch.bfloat16) * 0.05)(B, H, S, Dh)),
    }

def reference(q, k, v):
    scale = q.shape[-1] ** -0.5
    s = torch.einsum('bhqd,bhkd->bhqk', q, k) * scale
    p = _softmax(s, axis=-1)
    return torch.einsum('bhqk,bhkd->bhqd', p, v)
```

```asm
; @launch grid=(256,1,1) block=(512,1,1) lds=157696
.amdgcn_target "amdgcn-amd-amdhsa--gfx950"
.text
.p2align 12
.fill 320, 4, 0xbf810000
.globl standalone__fused_io_aware_attn__prompt_kernel
.p2align 8
.type standalone__fused_io_aware_attn__prompt_kernel,@function
standalone__fused_io_aware_attn__prompt_kernel:
    s_cmp_ge_u32 s2, 256
    s_cbranch_scc1 L_end
    s_load_dwordx8 s[4:11], s[0:1], 0
    v_lshrrev_b32 v12, 6, v0
    v_and_b32 v13, 31, v0
    v_readfirstlane_b32 s20, v12
    v_and_b32 v14, 63, v0
    v_lshlrev_b32 v13, 5, v13
    v_bfe_u32 v15, v0, 5, 1
    v_lshl_add_u32 v1, v15, 4, v13
    v_lshlrev_b32 v2, 4, v14
    s_and_b32 s21, s2, 7
    s_lshr_b32 s30, s2, 6
    s_lshl_b32 s21, s21, 2
    s_add_u32 s21, s21, s30
    s_lshl_b32 s21, s21, 16
    s_bfe_u32 s30, s2, 0x30003
    s_lshl_b32 s30, s30, 13
    s_add_u32 s25, s30, s21
    s_and_b32 s22, s20, 3
    s_lshr_b32 s23, s20, 2
    s_lshl_b32 s30, s22, 11
    s_add_u32 s25, s25, s30
    s_lshl_b32 s30, s23, 10
    s_add_u32 s25, s25, s30
    v_add_u32 v16, s25, v1
    s_lshl_b32 s30, s23, 15
    s_add_u32 s31, s30, s21
    v_add_u32 v17, s31, v1
    s_mov_b32 s14, 139264
    s_mov_b32 s15, 0x20000
    s_lshr_b32 s31, s22, 1
    s_lshl_b32 s31, s31, 10
    s_add_u32 s30, s30, s31
    s_and_b32 s24, s20, 1
    s_lshl_b32 s24, s24, 16
    s_add_u32 s24, s24, 8192
    s_add_u32 m0, s30, s24
    s_bitcmp1_b32 s20, 0
    s_cselect_b64 s[28:29], -1, 0
    v_cndmask_b32 v11, v1, v2, s[28:29]
    s_waitcnt lgkmcnt(0)
    global_load_dwordx4 v[20:23], v16, s[4:5]
    global_load_dwordx4 v[28:31], v17, s[6:7]
    s_cselect_b64 s[12:13], s[8:9], s[6:7]
    s_add_u32 s12, s12, s21
    s_addc_u32 s13, s13, 0
    s_sub_u32 s12, s12, s24
    s_subb_u32 s13, s13, 0
    buffer_load_dwordx4 v11, s[12:15], m0 offen lds
    s_mov_b32 s16, s10
    s_mov_b32 s17, s11
    s_mov_b32 s18, 0x200000
    s_mov_b32 s19, 0x20000
    s_xor_b32 s26, s25, 1024
    v_and_b32 v16, 1, v0
    v_subrev_u32 v16, 1, v16
    v_and_b32 v16, 0x3f80, v16
    v_mov_b32 v17, 0
    v_mov_b32 v18, v16
    v_mov_b32 v19, 0
    s_lshl_b32 s30, s20, 10
    v_add_u32 v12, s30, v2
    ds_write_b128 v12, v[16:19] offset:0
    v_add_u32 v136, 139264, v12
    v_xor_b32 v137, 0x1000, v12
    v_add_u32 v137, 139264, v137
    s_lshl_b32 s30, s23, 15
    s_add_u32 s31, s30, 8192
    v_add_u32 v3, s31, v2
    v_and_b32 v12, 15, v0
    v_lshlrev_b32 v12, 3, v12
    v_bfe_u32 v13, v0, 5, 1
    v_lshl_add_u32 v13, v13, 8, v12
    s_add_u32 s31, s30, 73728
    v_add_u32 v13, s31, v13
    v_and_b32 v12, 16, v12
    v_add_u32 v14, 128, v12
    v_and_b32 v15, 16, v0
    v_cmp_eq_u32 vcc, 0, v15
    v_mov_b32 v15, 4096
    v_mov_b32 v6, 0xdddddddd
    v_cndmask_b32 v4, v14, v13, vcc
    v_cndmask_b32 v5, 0, v15, vcc
    s_addk_i32 m0, 0x800
    s_nop 0
    buffer_load_dwordx4 v11, s[12:15], m0 offen lds
    s_addk_i32 m0, 0x800
    s_nop 0
    buffer_load_dwordx4 v11, s[12:15], m0 offen lds
    s_mul_i32 s30, s20, 2304
    s_xor_b32 s31, s20, 4
    s_mul_i32 s31, s31, 2304
    s_add_u32 s30, s30, 139264
    s_add_u32 s31, s31, 139264
    v_lshrrev_b32 v12, 2, v2
    v_add_u32 v7, s30, v2
    v_add_u32 v9, s31, v2
    v_add_u32 v8, s30, v12
    v_add_u32 v10, s31, v12
    v_mov_b32 v84, 0
    v_mov_b32 v85, 0
    v_mov_b32 v86, 0
    v_mov_b32 v87, 0
    v_mov_b32 v88, 0
    v_mov_b32 v89, 0
    v_mov_b32 v90, 0
    v_mov_b32 v91, 0
    v_mov_b32 v92, 0
    v_mov_b32 v93, 0
    v_mov_b32 v94, 0
    v_mov_b32 v95, 0
    v_mov_b32 v96, 0
    v_mov_b32 v97, 0
    v_mov_b32 v98, 0
    v_mov_b32 v99, 0
    v_mov_b32 v100, 0
    v_mov_b32 v101, 0
    v_mov_b32 v102, 0
    v_mov_b32 v103, 0
    v_mov_b32 v104, 0
    v_mov_b32 v105, 0
    v_mov_b32 v106, 0
    v_mov_b32 v107, 0
    v_mov_b32 v108, 0
    v_mov_b32 v109, 0
    v_mov_b32 v110, 0
    v_mov_b32 v111, 0
    v_mov_b32 v112, 0
    v_mov_b32 v113, 0
    v_mov_b32 v114, 0
    v_mov_b32 v115, 0
    s_waitcnt vmcnt(4)
    v_lshlrev_b32 v12, 16, v20
    v_and_b32 v13, 0xffff0000, v20
    v_lshlrev_b32 v14, 16, v21
    v_and_b32 v15, 0xffff0000, v21
    v_lshlrev_b32 v16, 16, v22
    v_and_b32 v17, 0xffff0000, v22
    v_lshlrev_b32 v18, 16, v23
    v_and_b32 v19, 0xffff0000, v23
    v_mul_f32 v12, 0x3eb8aa3b, v12
    v_mul_f32 v13, 0x3eb8aa3b, v13
    v_mul_f32 v14, 0x3eb8aa3b, v14
    v_mul_f32 v15, 0x3eb8aa3b, v15
    v_mul_f32 v16, 0x3eb8aa3b, v16
    v_mul_f32 v17, 0x3eb8aa3b, v17
    v_mul_f32 v18, 0x3eb8aa3b, v18
    v_mul_f32 v19, 0x3eb8aa3b, v19
    v_cvt_pk_bf16_f32 v20, v12, v13
    v_cvt_pk_bf16_f32 v21, v14, v15
    v_cvt_pk_bf16_f32 v22, v16, v17
    v_cvt_pk_bf16_f32 v23, v18, v19
    ds_write_b128 v136, v[20:23]
    s_waitcnt vmcnt(3)
    v_mfma_f32_32x32x16_bf16 v[52:67], v[28:31], v[20:23], 0
    s_nop 11
    v_exp_f32 v52, v52
    v_exp_f32 v53, v53
    v_exp_f32 v54, v54
    v_exp_f32 v55, v55
    v_exp_f32 v56, v56
    v_exp_f32 v57, v57
    v_exp_f32 v58, v58
    v_exp_f32 v59, v59
    v_exp_f32 v60, v60
    v_exp_f32 v61, v61
    v_exp_f32 v62, v62
    v_exp_f32 v63, v63
    v_exp_f32 v64, v64
    v_exp_f32 v65, v65
    v_exp_f32 v66, v66
    v_exp_f32 v67, v67
    s_waitcnt vmcnt(2) lgkmcnt(0)
    s_barrier
    ds_read_b128 v[24:27], v137
    ds_read_b64_tr_b16 v[36:37], v4 offset:0
    ds_read_b64_tr_b16 v[38:39], v4 offset:128
    ds_read_b64_tr_b16 v[44:45], v4 offset:512
    ds_read_b64_tr_b16 v[46:47], v4 offset:640
    ds_read_b128 v[32:35], v3 offset:1024
    s_addk_i32 m0, 0x800
    s_waitcnt lgkmcnt(5)
    v_mfma_f32_32x32x16_bf16 v[68:83], v[28:31], v[24:27], 0
    buffer_load_dwordx4 v11, s[12:15], m0 offen lds
    s_waitcnt lgkmcnt(3)
    v_smfmac_f32_32x32x32_bf16 v[84:99], v[36:39], v[52:59], v6
    s_addk_i32 m0, 0x800
    s_waitcnt lgkmcnt(0)
    v_smfmac_f32_32x32x32_bf16 v[84:99], v[44:47], v[60:67], v6
    ds_read_b64_tr_b16 v[40:41], v4 offset:1024
    ds_read_b64_tr_b16 v[42:43], v4 offset:1152
    buffer_load_dwordx4 v11, s[12:15], m0 offen lds
    s_nop 5
    v_exp_f32 v68, v68
    v_exp_f32 v69, v69
    v_exp_f32 v70, v70
    v_exp_f32 v71, v71
    v_exp_f32 v72, v72
    v_exp_f32 v73, v73
    v_exp_f32 v74, v74
    v_mfma_f32_32x32x16_bf16 v[52:67], v[32:35], v[20:23], 0
    ds_read_b64_tr_b16 v[48:49], v4 offset:1536
    ds_read_b64_tr_b16 v[50:51], v4 offset:1664
    s_addk_i32 m0, 0x800
    v_exp_f32 v75, v75
    v_exp_f32 v76, v76
    v_exp_f32 v77, v77
    v_exp_f32 v78, v78
    v_exp_f32 v79, v79
    v_smfmac_f32_32x32x32_bf16 v[100:115], v[36:39], v[68:75], v6
    s_waitcnt lgkmcnt(0)
    buffer_load_dwordx4 v11, s[12:15], m0 offen lds
    s_waitcnt vmcnt(3)
    s_barrier
    ds_read_b128 v[28:31], v3 offset:2048
    s_cmp_eq_u32 s23, 0
    s_cbranch_scc1 L_t1
    s_setprio 1
L_t1:
    v_exp_f32 v80, v80
    v_exp_f32 v81, v81
    v_exp_f32 v82, v82
    v_exp_f32 v83, v83
    v_exp_f32 v52, v52
    v_exp_f32 v53, v53
    v_smfmac_f32_32x32x32_bf16 v[100:115], v[44:47], v[76:83], v6
    ds_read_b64_tr_b16 v[36:37], v4 offset:2048
    s_addk_i32 m0, 0x800
    v_exp_f32 v54, v54
    v_exp_f32 v55, v55
    v_exp_f32 v56, v56
    v_exp_f32 v57, v57
    v_exp_f32 v58, v58
    v_mfma_f32_32x32x16_bf16 v[68:83], v[32:35], v[24:27], 0
    ds_read_b64_tr_b16 v[38:39], v4 offset:2176
    buffer_load_dwordx4 v11, s[12:15], m0 offen lds
    v_exp_f32 v59, v59
    v_exp_f32 v60, v60
    v_exp_f32 v61, v61
    v_exp_f32 v62, v62
    v_exp_f32 v63, v63
    v_smfmac_f32_32x32x32_bf16 v[84:99], v[40:43], v[52:59], v6
    ds_read_b128 v[32:35], v3 offset:3072
    s_addk_i32 m0, 0x800
    v_exp_f32 v64, v64
    v_exp_f32 v65, v65
    v_exp_f32 v66, v66
    v_exp_f32 v67, v67
    v_exp_f32 v68, v68
    v_exp_f32 v69, v69
    v_smfmac_f32_32x32x32_bf16 v[84:99], v[48:51], v[60:67], v6
    ds_read_b64_tr_b16 v[44:45], v4 offset:2560
    s_waitcnt lgkmcnt(4)
    buffer_load_dwordx4 v11, s[12:15], m0 offen lds
    v_exp_f32 v70, v70
    v_exp_f32 v71, v71
    v_exp_f32 v72, v72
    v_exp_f32 v73, v73
    v_exp_f32 v74, v74
    v_mfma_f32_32x32x16_bf16 v[52:67], v[28:31], v[20:23], 0
    ds_read_b64_tr_b16 v[46:47], v4 offset:2688
    v_exp_f32 v75, v75
    v_exp_f32 v76, v76
    v_exp_f32 v77, v77
    v_exp_f32 v78, v78
    v_exp_f32 v79, v79
    v_smfmac_f32_32x32x32_bf16 v[100:115], v[40:43], v[68:75], v6
    s_waitcnt lgkmcnt(0)
    v_exp_f32 v80, v80
    v_exp_f32 v81, v81
    v_exp_f32 v82, v82
    v_exp_f32 v83, v83
    v_exp_f32 v52, v52
    v_exp_f32 v53, v53
    v_smfmac_f32_32x32x32_bf16 v[100:115], v[48:51], v[76:83], v6
    ds_read_b64_tr_b16 v[40:41], v4 offset:3072
    s_addk_i32 m0, 0x800
    v_exp_f32 v54, v54
    v_exp_f32 v55, v55
    v_exp_f32 v56, v56
    v_exp_f32 v57, v57
    v_exp_f32 v58, v58
    v_mfma_f32_32x32x16_bf16 v[68:83], v[28:31], v[24:27], 0
    ds_read_b64_tr_b16 v[42:43], v4 offset:3200
    buffer_load_dwordx4 v11, s[12:15], m0 offen lds
    v_exp_f32 v59, v59
    v_exp_f32 v60, v60
    v_exp_f32 v61, v61
    v_exp_f32 v62, v62
    v_exp_f32 v63, v63
    v_smfmac_f32_32x32x32_bf16 v[84:99], v[36:39], v[52:59], v6
    ds_read_b128 v[28:31], v3 offset:4096
    s_addk_i32 m0, 0x800
    v_exp_f32 v64, v64
    v_exp_f32 v65, v65
    v_exp_f32 v66, v66
    v_exp_f32 v67, v67
    v_exp_f32 v68, v68
    v_exp_f32 v69, v69
    v_smfmac_f32_32x32x32_bf16 v[84:99], v[44:47], v[60:67], v6
    ds_read_b64_tr_b16 v[48:49], v4 offset:3584
    buffer_load_dwordx4 v11, s[12:15], m0 offen lds
    v_exp_f32 v70, v70
    v_exp_f32 v71, v71
    v_exp_f32 v72, v72
    v_exp_f32 v73, v73
    v_exp_f32 v74, v74
    v_mfma_f32_32x32x16_bf16 v[52:67], v[32:35], v[20:23], 0
    ds_read_b64_tr_b16 v[50:51], v4 offset:3712
    v_exp_f32 v75, v75
    v_exp_f32 v76, v76
    v_exp_f32 v77, v77
    v_exp_f32 v78, v78
    v_exp_f32 v79, v79
    v_smfmac_f32_32x32x32_bf16 v[100:115], v[36:39], v[68:75], v6
    s_waitcnt lgkmcnt(0)
    v_exp_f32 v80, v80
    v_exp_f32 v81, v81
    v_exp_f32 v82, v82
    v_exp_f32 v83, v83
    v_exp_f32 v52, v52
    v_exp_f32 v53, v53
    v_smfmac_f32_32x32x32_bf16 v[100:115], v[44:47], v[76:83], v6
    ds_read_b64_tr_b16 v[36:37], v4 offset:4096
    s_addk_i32 m0, 0x800
    v_exp_f32 v54, v54
    v_exp_f32 v55, v55
    v_exp_f32 v56, v56
    v_exp_f32 v57, v57
    v_exp_f32 v58, v58
    v_mfma_f32_32x32x16_bf16 v[68:83], v[32:35], v[24:27], 0
    ds_read_b64_tr_b16 v[38:39], v4 offset:4224
    buffer_load_dwordx4 v11, s[12:15], m0 offen lds
    v_exp_f32 v59, v59
    v_exp_f32 v60, v60
    v_exp_f32 v61, v61
    v_exp_f32 v62, v62
    v_exp_f32 v63, v63
    v_smfmac_f32_32x32x32_bf16 v[84:99], v[40:43], v[52:59], v6
    ds_read_b128 v[32:35], v3 offset:5120
    s_addk_i32 m0, 0x800
    s_setprio 0
    v_exp_f32 v64, v64
    v_exp_f32 v65, v65
    v_exp_f32 v66, v66
    v_exp_f32 v67, v67
    v_exp_f32 v68, v68
    v_exp_f32 v69, v69
    v_smfmac_f32_32x32x32_bf16 v[84:99], v[48:51], v[60:67], v6
    ds_read_b64_tr_b16 v[44:45], v4 offset:4608
    buffer_load_dwordx4 v11, s[12:15], m0 offen lds
    v_exp_f32 v70, v70
    v_exp_f32 v71, v71
    v_exp_f32 v72, v72
    v_exp_f32 v73, v73
    v_exp_f32 v74, v74
    v_mfma_f32_32x32x16_bf16 v[52:67], v[28:31], v[20:23], 0
    ds_read_b64_tr_b16 v[46:47], v4 offset:4736
    v_exp_f32 v75, v75
    v_exp_f32 v76, v76
    v_exp_f32 v77, v77
    v_exp_f32 v78, v78
    v_exp_f32 v79, v79
    v_smfmac_f32_32x32x32_bf16 v[100:115], v[40:43], v[68:75], v6
    s_waitcnt lgkmcnt(0)
    v_add_u32 v4, v5, v4
    s_waitcnt vmcnt(6)
    s_barrier
    s_cmp_eq_u32 s23, 0
    s_cbranch_scc1 L_t2
    s_setprio 1
L_t2:
    v_exp_f32 v80, v80
    v_exp_f32 v81, v81
    v_exp_f32 v82, v82
    v_exp_f32 v83, v83
    v_exp_f32 v52, v52
    v_exp_f32 v53, v53
    v_smfmac_f32_32x32x32_bf16 v[100:115], v[48:51], v[76:83], v6
    ds_read_b64_tr_b16 v[40:41], v4 offset:1024
    s_addk_i32 m0, 0x800
    v_exp_f32 v54, v54
    v_exp_f32 v55, v55
    v_exp_f32 v56, v56
    v_exp_f32 v57, v57
    v_exp_f32 v58, v58
    v_mfma_f32_32x32x16_bf16 v[68:83], v[28:31], v[24:27], 0
    ds_read_b64_tr_b16 v[42:43], v4 offset:1152
    buffer_load_dwordx4 v11, s[12:15], m0 offen lds
    v_exp_f32 v59, v59
    v_exp_f32 v60, v60
    v_exp_f32 v61, v61
    v_exp_f32 v62, v62
    v_exp_f32 v63, v63
    v_smfmac_f32_32x32x32_bf16 v[84:99], v[36:39], v[52:59], v6
    ds_read_b128 v[28:31], v3 offset:6144
    s_addk_i32 m0, 0x800
    v_exp_f32 v64, v64
    v_exp_f32 v65, v65
    v_exp_f32 v66, v66
    v_exp_f32 v67, v67
    v_exp_f32 v68, v68
    v_exp_f32 v69, v69
    v_smfmac_f32_32x32x32_bf16 v[84:99], v[44:47], v[60:67], v6
    ds_read_b64_tr_b16 v[48:49], v4 offset:1536
    buffer_load_dwordx4 v11, s[12:15], m0 offen lds
    v_exp_f32 v70, v70
    v_exp_f32 v71, v71
    v_exp_f32 v72, v72
    v_exp_f32 v73, v73
    v_exp_f32 v74, v74
    v_mfma_f32_32x32x16_bf16 v[52:67], v[32:35], v[20:23], 0
    ds_read_b64_tr_b16 v[50:51], v4 offset:1664
    v_exp_f32 v75, v75
    v_exp_f32 v76, v76
    v_exp_f32 v77, v77
    v_exp_f32 v78, v78
    v_exp_f32 v79, v79
    v_smfmac_f32_32x32x32_bf16 v[100:115], v[36:39], v[68:75], v6
    s_waitcnt lgkmcnt(0)
    v_exp_f32 v80, v80
    v_exp_f32 v81, v81
    v_exp_f32 v82, v82
    v_exp_f32 v83, v83
    v_exp_f32 v52, v52
    v_exp_f32 v53, v53
    v_smfmac_f32_32x32x32_bf16 v[100:115], v[44:47], v[76:83], v6
    ds_read_b64_tr_b16 v[36:37], v4 offset:2048
    s_addk_i32 m0, 0x800
    v_exp_f32 v54, v54
    v_exp_f32 v55, v55
    v_exp_f32 v56, v56
    v_exp_f32 v57, v57
    v_exp_f32 v58, v58
    v_mfma_f32_32x32x16_bf16 v[68:83], v[32:35], v[24:27], 0
    ds_read_b64_tr_b16 v[38:39], v4 offset:2176
    buffer_load_dwordx4 v11, s[12:15], m0 offen lds
    v_exp_f32 v59, v59
    v_exp_f32 v60, v60
    v_exp_f32 v61, v61
    v_exp_f32 v62, v62
    v_exp_f32 v63, v63
    v_smfmac_f32_32x32x32_bf16 v[84:99], v[40:43], v[52:59], v6
    ds_read_b128 v[32:35], v3 offset:7168
    s_addk_i32 m0, 0x800
    v_exp_f32 v64, v64
    v_exp_f32 v65, v65
    v_exp_f32 v66, v66
    v_exp_f32 v67, v67
    v_exp_f32 v68, v68
    v_exp_f32 v69, v69
    v_smfmac_f32_32x32x32_bf16 v[84:99], v[48:51], v[60:67], v6
    ds_read_b64_tr_b16 v[44:45], v4 offset:2560
    buffer_load_dwordx4 v11, s[12:15], m0 offen lds
    v_exp_f32 v70, v70
    v_exp_f32 v71, v71
    v_exp_f32 v72, v72
    v_exp_f32 v73, v73
    v_exp_f32 v74, v74
    v_mfma_f32_32x32x16_bf16 v[52:67], v[28:31], v[20:23], 0
    ds_read_b64_tr_b16 v[46:47], v4 offset:2688
    v_exp_f32 v75, v75
    v_exp_f32 v76, v76
    v_exp_f32 v77, v77
    v_exp_f32 v78, v78
    v_exp_f32 v79, v79
    v_smfmac_f32_32x32x32_bf16 v[100:115], v[40:43], v[68:75], v6
    s_waitcnt lgkmcnt(0)
    v_exp_f32 v80, v80
    v_exp_f32 v81, v81
    v_exp_f32 v82, v82
    v_exp_f32 v83, v83
    v_exp_f32 v52, v52
    v_exp_f32 v53, v53
    v_smfmac_f32_32x32x32_bf16 v[100:115], v[48:51], v[76:83], v6
    ds_read_b64_tr_b16 v[40:41], v4 offset:3072
    v_exp_f32 v54, v54
    v_exp_f32 v55, v55
    v_exp_f32 v56, v56
    v_exp_f32 v57, v57
    v_exp_f32 v58, v58
    v_mfma_f32_32x32x16_bf16 v[68:83], v[28:31], v[24:27], 0
    ds_read_b64_tr_b16 v[42:43], v4 offset:3200
    v_exp_f32 v59, v59
    v_exp_f32 v60, v60
    v_exp_f32 v61, v61
    v_exp_f32 v62, v62
    v_exp_f32 v63, v63
    v_smfmac_f32_32x32x32_bf16 v[84:99], v[36:39], v[52:59], v6
    ds_read_b128 v[28:31], v3 offset:8192
    v_exp_f32 v64, v64
    v_exp_f32 v65, v65
    v_exp_f32 v66, v66
    v_exp_f32 v67, v67
    v_exp_f32 v68, v68
    v_exp_f32 v69, v69
    v_smfmac_f32_32x32x32_bf16 v[84:99], v[44:47], v[60:67], v6
    ds_read_b64_tr_b16 v[48:49], v4 offset:3584
    v_exp_f32 v70, v70
    v_exp_f32 v71, v71
    v_exp_f32 v72, v72
    v_exp_f32 v73, v73
    v_exp_f32 v74, v74
    v_mfma_f32_32x32x16_bf16 v[52:67], v[32:35], v[20:23], 0
    ds_read_b64_tr_b16 v[50:51], v4 offset:3712
    v_exp_f32 v75, v75
    v_exp_f32 v76, v76
    v_exp_f32 v77, v77
    v_exp_f32 v78, v78
    v_exp_f32 v79, v79
    v_smfmac_f32_32x32x32_bf16 v[100:115], v[36:39], v[68:75], v6
    s_waitcnt lgkmcnt(0)
    v_exp_f32 v80, v80
    v_exp_f32 v81, v81
    v_exp_f32 v82, v82
    v_exp_f32 v83, v83
    v_exp_f32 v52, v52
    v_exp_f32 v53, v53
    v_smfmac_f32_32x32x32_bf16 v[100:115], v[44:47], v[76:83], v6
    ds_read_b64_tr_b16 v[36:37], v4 offset:4096
    v_exp_f32 v54, v54
    v_exp_f32 v55, v55
    v_exp_f32 v56, v56
    v_exp_f32 v57, v57
    v_exp_f32 v58, v58
    v_mfma_f32_32x32x16_bf16 v[68:83], v[32:35], v[24:27], 0
    ds_read_b64_tr_b16 v[38:39], v4 offset:4224
    v_exp_f32 v59, v59
    v_exp_f32 v60, v60
    v_exp_f32 v61, v61
    v_exp_f32 v62, v62
    v_exp_f32 v63, v63
    v_smfmac_f32_32x32x32_bf16 v[84:99], v[40:43], v[52:59], v6
    ds_read_b128 v[32:35], v3 offset:9216
    v_exp_f32 v64, v64
    v_exp_f32 v65, v65
    v_exp_f32 v66, v66
    v_exp_f32 v67, v67
    v_exp_f32 v68, v68
    v_exp_f32 v69, v69
    v_smfmac_f32_32x32x32_bf16 v[84:99], v[48:51], v[60:67], v6
    ds_read_b64_tr_b16 v[44:45], v4 offset:4608
    v_exp_f32 v70, v70
    v_exp_f32 v71, v71
    v_exp_f32 v72, v72
    v_exp_f32 v73, v73
    v_exp_f32 v74, v74
    v_mfma_f32_32x32x16_bf16 v[52:67], v[28:31], v[20:23], 0
    ds_read_b64_tr_b16 v[46:47], v4 offset:4736
    v_exp_f32 v75, v75
    v_exp_f32 v76, v76
    v_exp_f32 v77, v77
    v_exp_f32 v78, v78
    v_exp_f32 v79, v79
    v_smfmac_f32_32x32x32_bf16 v[100:115], v[40:43], v[68:75], v6
    s_waitcnt lgkmcnt(0)
    v_add_u32 v4, v5, v4
    v_exp_f32 v80, v80
    v_exp_f32 v81, v81
    v_exp_f32 v82, v82
    v_exp_f32 v83, v83
    v_exp_f32 v52, v52
    v_exp_f32 v53, v53
    v_smfmac_f32_32x32x32_bf16 v[100:115], v[48:51], v[76:83], v6
    ds_read_b64_tr_b16 v[40:41], v4 offset:1024
    v_exp_f32 v54, v54
    v_exp_f32 v55, v55
    v_exp_f32 v56, v56
    v_exp_f32 v57, v57
    v_exp_f32 v58, v58
    v_mfma_f32_32x32x16_bf16 v[68:83], v[28:31], v[24:27], 0
    ds_read_b64_tr_b16 v[42:43], v4 offset:1152
    v_exp_f32 v59, v59
    v_exp_f32 v60, v60
    v_exp_f32 v61, v61
    v_exp_f32 v62, v62
    v_exp_f32 v63, v63
    v_smfmac_f32_32x32x32_bf16 v[84:99], v[36:39], v[52:59], v6
    ds_read_b128 v[28:31], v3 offset:10240
    v_exp_f32 v64, v64
    v_exp_f32 v65, v65
    v_exp_f32 v66, v66
    v_exp_f32 v67, v67
    v_exp_f32 v68, v68
    v_exp_f32 v69, v69
    v_smfmac_f32_32x32x32_bf16 v[84:99], v[44:47], v[60:67], v6
    ds_read_b64_tr_b16 v[48:49], v4 offset:1536
    v_exp_f32 v70, v70
    v_exp_f32 v71, v71
    v_exp_f32 v72, v72
    v_exp_f32 v73, v73
    v_exp_f32 v74, v74
    v_mfma_f32_32x32x16_bf16 v[52:67], v[32:35], v[20:23], 0
    ds_read_b64_tr_b16 v[50:51], v4 offset:1664
    v_exp_f32 v75, v75
    v_exp_f32 v76, v76
    v_exp_f32 v77, v77
    v_exp_f32 v78, v78
    v_exp_f32 v79, v79
    v_smfmac_f32_32x32x32_bf16 v[100:115], v[36:39], v[68:75], v6
    s_waitcnt lgkmcnt(0)
    s_setprio 0
    v_exp_f32 v80, v80
    v_exp_f32 v81, v81
    v_exp_f32 v82, v82
    v_exp_f32 v83, v83
    v_exp_f32 v52, v52
    v_exp_f32 v53, v53
    v_smfmac_f32_32x32x32_bf16 v[100:115], v[44:47], v[76:83], v6
    ds_read_b64_tr_b16 v[36:37], v4 offset:2048
    v_exp_f32 v54, v54
    v_exp_f32 v55, v55
    v_exp_f32 v56, v56
    v_exp_f32 v57, v57
    v_exp_f32 v58, v58
    v_mfma_f32_32x32x16_bf16 v[68:83], v[32:35], v[24:27], 0
    ds_read_b64_tr_b16 v[38:39], v4 offset:2176
    v_exp_f32 v59, v59
    v_exp_f32 v60, v60
    v_exp_f32 v61, v61
    v_exp_f32 v62, v62
    v_exp_f32 v63, v63
    v_smfmac_f32_32x32x32_bf16 v[84:99], v[40:43], v[52:59], v6
    ds_read_b128 v[32:35], v3 offset:11264
    v_exp_f32 v64, v64
    v_exp_f32 v65, v65
    v_exp_f32 v66, v66
    v_exp_f32 v67, v67
    v_exp_f32 v68, v68
    v_exp_f32 v69, v69
    v_smfmac_f32_32x32x32_bf16 v[84:99], v[48:51], v[60:67], v6
    ds_read_b64_tr_b16 v[44:45], v4 offset:2560
    v_exp_f32 v70, v70
    v_exp_f32 v71, v71
    v_exp_f32 v72, v72
    v_exp_f32 v73, v73
    v_exp_f32 v74, v74
    v_mfma_f32_32x32x16_bf16 v[52:67], v[28:31], v[20:23], 0
    ds_read_b64_tr_b16 v[46:47], v4 offset:2688
    v_exp_f32 v75, v75
    v_exp_f32 v76, v76
    v_exp_f32 v77, v77
    v_exp_f32 v78, v78
    v_exp_f32 v79, v79
    v_smfmac_f32_32x32x32_bf16 v[100:115], v[40:43], v[68:75], v6
    s_waitcnt lgkmcnt(0)
    s_waitcnt vmcnt(0)
    s_barrier
    s_cmp_eq_u32 s23, 0
    s_cbranch_scc1 L_t3
    s_setprio 1
L_t3:
    v_exp_f32 v80, v80
    v_exp_f32 v81, v81
    v_exp_f32 v82, v82
    v_exp_f32 v83, v83
    v_exp_f32 v52, v52
    v_exp_f32 v53, v53
    v_smfmac_f32_32x32x32_bf16 v[100:115], v[48:51], v[76:83], v6
    ds_read_b64_tr_b16 v[40:41], v4 offset:3072
    v_exp_f32 v54, v54
    v_exp_f32 v55, v55
    v_exp_f32 v56, v56
    v_exp_f32 v57, v57
    v_exp_f32 v58, v58
    v_mfma_f32_32x32x16_bf16 v[68:83], v[28:31], v[24:27], 0
    ds_read_b64_tr_b16 v[42:43], v4 offset:3200
    v_exp_f32 v59, v59
    v_exp_f32 v60, v60
    v_exp_f32 v61, v61
    v_exp_f32 v62, v62
    v_exp_f32 v63, v63
    v_smfmac_f32_32x32x32_bf16 v[84:99], v[36:39], v[52:59], v6
    ds_read_b128 v[28:31], v3 offset:12288
    v_exp_f32 v64, v64
    v_exp_f32 v65, v65
    v_exp_f32 v66, v66
    v_exp_f32 v67, v67
    v_exp_f32 v68, v68
    v_exp_f32 v69, v69
    v_smfmac_f32_32x32x32_bf16 v[84:99], v[44:47], v[60:67], v6
    ds_read_b64_tr_b16 v[48:49], v4 offset:3584
    v_exp_f32 v70, v70
    v_exp_f32 v71, v71
    v_exp_f32 v72, v72
    v_exp_f32 v73, v73
    v_exp_f32 v74, v74
    v_mfma_f32_32x32x16_bf16 v[52:67], v[32:35], v[20:23], 0
    ds_read_b64_tr_b16 v[50:51], v4 offset:3712
    v_exp_f32 v75, v75
    v_exp_f32 v76, v76
    v_exp_f32 v77, v77
    v_exp_f32 v78, v78
    v_exp_f32 v79, v79
    v_smfmac_f32_32x32x32_bf16 v[100:115], v[36:39], v[68:75], v6
    s_waitcnt lgkmcnt(0)
    v_exp_f32 v80, v80
    v_exp_f32 v81, v81
    v_exp_f32 v82, v82
    v_exp_f32 v83, v83
    v_exp_f32 v52, v52
    v_exp_f32 v53, v53
    v_smfmac_f32_32x32x32_bf16 v[100:115], v[44:47], v[76:83], v6
    ds_read_b64_tr_b16 v[36:37], v4 offset:4096
    v_exp_f32 v54, v54
    v_exp_f32 v55, v55
    v_exp_f32 v56, v56
    v_exp_f32 v57, v57
    v_exp_f32 v58, v58
    v_mfma_f32_32x32x16_bf16 v[68:83], v[32:35], v[24:27], 0
    ds_read_b64_tr_b16 v[38:39], v4 offset:4224
    v_exp_f32 v59, v59
    v_exp_f32 v60, v60
    v_exp_f32 v61, v61
    v_exp_f32 v62, v62
    v_exp_f32 v63, v63
    v_smfmac_f32_32x32x32_bf16 v[84:99], v[40:43], v[52:59], v6
    ds_read_b128 v[32:35], v3 offset:13312
    v_exp_f32 v64, v64
    v_exp_f32 v65, v65
    v_exp_f32 v66, v66
    v_exp_f32 v67, v67
    v_exp_f32 v68, v68
    v_exp_f32 v69, v69
    v_smfmac_f32_32x32x32_bf16 v[84:99], v[48:51], v[60:67], v6
    ds_read_b64_tr_b16 v[44:45], v4 offset:4608
    v_exp_f32 v70, v70
    v_exp_f32 v71, v71
    v_exp_f32 v72, v72
    v_exp_f32 v73, v73
    v_exp_f32 v74, v74
    v_mfma_f32_32x32x16_bf16 v[52:67], v[28:31], v[20:23], 0
    ds_read_b64_tr_b16 v[46:47], v4 offset:4736
    v_exp_f32 v75, v75
    v_exp_f32 v76, v76
    v_exp_f32 v77, v77
    v_exp_f32 v78, v78
    v_exp_f32 v79, v79
    v_smfmac_f32_32x32x32_bf16 v[100:115], v[40:43], v[68:75], v6
    s_waitcnt lgkmcnt(0)
    v_add_u32 v4, v5, v4
    v_exp_f32 v80, v80
    v_exp_f32 v81, v81
    v_exp_f32 v82, v82
    v_exp_f32 v83, v83
    v_exp_f32 v52, v52
    v_exp_f32 v53, v53
    v_smfmac_f32_32x32x32_bf16 v[100:115], v[48:51], v[76:83], v6
    ds_read_b64_tr_b16 v[40:41], v4 offset:1024
    v_exp_f32 v54, v54
    v_exp_f32 v55, v55
    v_exp_f32 v56, v56
    v_exp_f32 v57, v57
    v_exp_f32 v58, v58
    v_mfma_f32_32x32x16_bf16 v[68:83], v[28:31], v[24:27], 0
    ds_read_b64_tr_b16 v[42:43], v4 offset:1152
    v_exp_f32 v59, v59
    v_exp_f32 v60, v60
    v_exp_f32 v61, v61
    v_exp_f32 v62, v62
    v_exp_f32 v63, v63
    v_smfmac_f32_32x32x32_bf16 v[84:99], v[36:39], v[52:59], v6
    ds_read_b128 v[28:31], v3 offset:14336
    v_exp_f32 v64, v64
    v_exp_f32 v65, v65
    v_exp_f32 v66, v66
    v_exp_f32 v67, v67
    v_exp_f32 v68, v68
    v_exp_f32 v69, v69
    v_smfmac_f32_32x32x32_bf16 v[84:99], v[44:47], v[60:67], v6
    ds_read_b64_tr_b16 v[48:49], v4 offset:1536
    v_exp_f32 v70, v70
    v_exp_f32 v71, v71
    v_exp_f32 v72, v72
    v_exp_f32 v73, v73
    v_exp_f32 v74, v74
    v_mfma_f32_32x32x16_bf16 v[52:67], v[32:35], v[20:23], 0
    ds_read_b64_tr_b16 v[50:51], v4 offset:1664
    v_exp_f32 v75, v75
    v_exp_f32 v76, v76
    v_exp_f32 v77, v77
    v_exp_f32 v78, v78
    v_exp_f32 v79, v79
    v_smfmac_f32_32x32x32_bf16 v[100:115], v[36:39], v[68:75], v6
    s_waitcnt lgkmcnt(0)
    v_exp_f32 v80, v80
    v_exp_f32 v81, v81
    v_exp_f32 v82, v82
    v_exp_f32 v83, v83
    v_exp_f32 v52, v52
    v_exp_f32 v53, v53
    v_smfmac_f32_32x32x32_bf16 v[100:115], v[44:47], v[76:83], v6
    ds_read_b64_tr_b16 v[36:37], v4 offset:2048
    v_exp_f32 v54, v54
    v_exp_f32 v55, v55
    v_exp_f32 v56, v56
    v_exp_f32 v57, v57
    v_exp_f32 v58, v58
    v_mfma_f32_32x32x16_bf16 v[68:83], v[32:35], v[24:27], 0
    ds_read_b64_tr_b16 v[38:39], v4 offset:2176
    v_exp_f32 v59, v59
    v_exp_f32 v60, v60
    v_exp_f32 v61, v61
    v_exp_f32 v62, v62
    v_exp_f32 v63, v63
    v_smfmac_f32_32x32x32_bf16 v[84:99], v[40:43], v[52:59], v6
    ds_read_b128 v[32:35], v3 offset:15360
    v_exp_f32 v64, v64
    v_exp_f32 v65, v65
    v_exp_f32 v66, v66
    v_exp_f32 v67, v67
    v_exp_f32 v68, v68
    v_exp_f32 v69, v69
    v_smfmac_f32_32x32x32_bf16 v[84:99], v[48:51], v[60:67], v6
    ds_read_b64_tr_b16 v[44:45], v4 offset:2560
    v_exp_f32 v70, v70
    v_exp_f32 v71, v71
    v_exp_f32 v72, v72
    v_exp_f32 v73, v73
    v_exp_f32 v74, v74
    v_mfma_f32_32x32x16_bf16 v[52:67], v[28:31], v[20:23], 0
    ds_read_b64_tr_b16 v[46:47], v4 offset:2688
    v_exp_f32 v75, v75
    v_exp_f32 v76, v76
    v_exp_f32 v77, v77
    v_exp_f32 v78, v78
    v_exp_f32 v79, v79
    v_smfmac_f32_32x32x32_bf16 v[100:115], v[40:43], v[68:75], v6
    s_waitcnt lgkmcnt(0)
    v_exp_f32 v80, v80
    v_exp_f32 v81, v81
    v_exp_f32 v82, v82
    v_exp_f32 v83, v83
    v_exp_f32 v52, v52
    v_exp_f32 v53, v53
    v_smfmac_f32_32x32x32_bf16 v[100:115], v[48:51], v[76:83], v6
    ds_read_b64_tr_b16 v[40:41], v4 offset:3072
    v_exp_f32 v54, v54
    v_exp_f32 v55, v55
    v_exp_f32 v56, v56
    v_exp_f32 v57, v57
    v_exp_f32 v58, v58
    v_mfma_f32_32x32x16_bf16 v[68:83], v[28:31], v[24:27], 0
    ds_read_b64_tr_b16 v[42:43], v4 offset:3200
    v_exp_f32 v59, v59
    v_exp_f32 v60, v60
    v_exp_f32 v61, v61
    v_exp_f32 v62, v62
    v_exp_f32 v63, v63
    v_smfmac_f32_32x32x32_bf16 v[84:99], v[36:39], v[52:59], v6
    ds_read_b128 v[28:31], v3 offset:16384
    v_exp_f32 v64, v64
    v_exp_f32 v65, v65
    v_exp_f32 v66, v66
    v_exp_f32 v67, v67
    v_exp_f32 v68, v68
    v_exp_f32 v69, v69
    v_smfmac_f32_32x32x32_bf16 v[84:99], v[44:47], v[60:67], v6
    ds_read_b64_tr_b16 v[48:49], v4 offset:3584
    v_exp_f32 v70, v70
    v_exp_f32 v71, v71
    v_exp_f32 v72, v72
    v_exp_f32 v73, v73
    v_exp_f32 v74, v74
    v_mfma_f32_32x32x16_bf16 v[52:67], v[32:35], v[20:23], 0
    ds_read_b64_tr_b16 v[50:51], v4 offset:3712
    v_exp_f32 v75, v75
    v_exp_f32 v76, v76
    v_exp_f32 v77, v77
    v_exp_f32 v78, v78
    v_exp_f32 v79, v79
    v_smfmac_f32_32x32x32_bf16 v[100:115], v[36:39], v[68:75], v6
    s_waitcnt lgkmcnt(0)
    v_exp_f32 v80, v80
    v_exp_f32 v81, v81
    v_exp_f32 v82, v82
    v_exp_f32 v83, v83
    v_exp_f32 v52, v52
    v_exp_f32 v53, v53
    v_smfmac_f32_32x32x32_bf16 v[100:115], v[44:47], v[76:83], v6
    ds_read_b64_tr_b16 v[36:37], v4 offset:4096
    v_exp_f32 v54, v54
    v_exp_f32 v55, v55
    v_exp_f32 v56, v56
    v_exp_f32 v57, v57
    v_exp_f32 v58, v58
    v_mfma_f32_32x32x16_bf16 v[68:83], v[32:35], v[24:27], 0
    ds_read_b64_tr_b16 v[38:39], v4 offset:4224
    v_exp_f32 v59, v59
    v_exp_f32 v60, v60
    v_exp_f32 v61, v61
    v_exp_f32 v62, v62
    v_exp_f32 v63, v63
    v_smfmac_f32_32x32x32_bf16 v[84:99], v[40:43], v[52:59], v6
    ds_read_b128 v[32:35], v3 offset:17408
    v_exp_f32 v64, v64
    v_exp_f32 v65, v65
    v_exp_f32 v66, v66
    v_exp_f32 v67, v67
    v_exp_f32 v68, v68
    v_exp_f32 v69, v69
    v_smfmac_f32_32x32x32_bf16 v[84:99], v[48:51], v[60:67], v6
    ds_read_b64_tr_b16 v[44:45], v4 offset:4608
    v_exp_f32 v70, v70
    v_exp_f32 v71, v71
    v_exp_f32 v72, v72
    v_exp_f32 v73, v73
    v_exp_f32 v74, v74
    v_mfma_f32_32x32x16_bf16 v[52:67], v[28:31], v[20:23], 0
    ds_read_b64_tr_b16 v[46:47], v4 offset:4736
    v_exp_f32 v75, v75
    v_exp_f32 v76, v76
    v_exp_f32 v77, v77
    v_exp_f32 v78, v78
    v_exp_f32 v79, v79
    v_smfmac_f32_32x32x32_bf16 v[100:115], v[40:43], v[68:75], v6
    s_waitcnt lgkmcnt(0)
    v_add_u32 v4, v5, v4
    v_exp_f32 v80, v80
    v_exp_f32 v81, v81
    v_exp_f32 v82, v82
    v_exp_f32 v83, v83
    v_exp_f32 v52, v52
    v_exp_f32 v53, v53
    v_smfmac_f32_32x32x32_bf16 v[100:115], v[48:51], v[76:83], v6
    ds_read_b64_tr_b16 v[40:41], v4 offset:1024
    v_exp_f32 v54, v54
    v_exp_f32 v55, v55
    v_exp_f32 v56, v56
    v_exp_f32 v57, v57
    v_exp_f32 v58, v58
    v_mfma_f32_32x32x16_bf16 v[68:83], v[28:31], v[24:27], 0
    ds_read_b64_tr_b16 v[42:43], v4 offset:1152
    v_exp_f32 v59, v59
    v_exp_f32 v60, v60
    v_exp_f32 v61, v61
    v_exp_f32 v62, v62
    v_exp_f32 v63, v63
    v_smfmac_f32_32x32x32_bf16 v[84:99], v[36:39], v[52:59], v6
    ds_read_b128 v[28:31], v3 offset:18432
    v_exp_f32 v64, v64
    v_exp_f32 v65, v65
    v_exp_f32 v66, v66
    v_exp_f32 v67, v67
    v_exp_f32 v68, v68
    v_exp_f32 v69, v69
    v_smfmac_f32_32x32x32_bf16 v[84:99], v[44:47], v[60:67], v6
    ds_read_b64_tr_b16 v[48:49], v4 offset:1536
    v_exp_f32 v70, v70
    v_exp_f32 v71, v71
    v_exp_f32 v72, v72
    v_exp_f32 v73, v73
    v_exp_f32 v74, v74
    v_mfma_f32_32x32x16_bf16 v[52:67], v[32:35], v[20:23], 0
    ds_read_b64_tr_b16 v[50:51], v4 offset:1664
    v_exp_f32 v75, v75
    v_exp_f32 v76, v76
    v_exp_f32 v77, v77
    v_exp_f32 v78, v78
    v_exp_f32 v79, v79
    v_smfmac_f32_32x32x32_bf16 v[100:115], v[36:39], v[68:75], v6
    s_waitcnt lgkmcnt(0)
    v_exp_f32 v80, v80
    v_exp_f32 v81, v81
    v_exp_f32 v82, v82
    v_exp_f32 v83, v83
    v_exp_f32 v52, v52
    v_exp_f32 v53, v53
    v_smfmac_f32_32x32x32_bf16 v[100:115], v[44:47], v[76:83], v6
    ds_read_b64_tr_b16 v[36:37], v4 offset:2048
    v_exp_f32 v54, v54
    v_exp_f32 v55, v55
    v_exp_f32 v56, v56
    v_exp_f32 v57, v57
    v_exp_f32 v58, v58
    v_mfma_f32_32x32x16_bf16 v[68:83], v[32:35], v[24:27], 0
    ds_read_b64_tr_b16 v[38:39], v4 offset:2176
    v_exp_f32 v59, v59
    v_exp_f32 v60, v60
    v_exp_f32 v61, v61
    v_exp_f32 v62, v62
    v_exp_f32 v63, v63
    v_smfmac_f32_32x32x32_bf16 v[84:99], v[40:43], v[52:59], v6
    ds_read_b128 v[32:35], v3 offset:19456
    v_exp_f32 v64, v64
    v_exp_f32 v65, v65
    v_exp_f32 v66, v66
    v_exp_f32 v67, v67
    v_exp_f32 v68, v68
    v_exp_f32 v69, v69
    v_smfmac_f32_32x32x32_bf16 v[84:99], v[48:51], v[60:67], v6
    ds_read_b64_tr_b16 v[44:45], v4 offset:2560
    v_exp_f32 v70, v70
    v_exp_f32 v71, v71
    v_exp_f32 v72, v72
    v_exp_f32 v73, v73
    v_exp_f32 v74, v74
    v_mfma_f32_32x32x16_bf16 v[52:67], v[28:31], v[20:23], 0
    ds_read_b64_tr_b16 v[46:47], v4 offset:2688
    v_exp_f32 v75, v75
    v_exp_f32 v76, v76
    v_exp_f32 v77, v77
    v_exp_f32 v78, v78
    v_exp_f32 v79, v79
    v_smfmac_f32_32x32x32_bf16 v[100:115], v[40:43], v[68:75], v6
    s_waitcnt lgkmcnt(0)
    v_exp_f32 v80, v80
    v_exp_f32 v81, v81
    v_exp_f32 v82, v82
    v_exp_f32 v83, v83
    v_exp_f32 v52, v52
    v_exp_f32 v53, v53
    v_smfmac_f32_32x32x32_bf16 v[100:115], v[48:51], v[76:83], v6
    ds_read_b64_tr_b16 v[40:41], v4 offset:3072
    v_exp_f32 v54, v54
    v_exp_f32 v55, v55
    v_exp_f32 v56, v56
    v_exp_f32 v57, v57
    v_exp_f32 v58, v58
    v_mfma_f32_32x32x16_bf16 v[68:83], v[28:31], v[24:27], 0
    ds_read_b64_tr_b16 v[42:43], v4 offset:3200
    v_exp_f32 v59, v59
    v_exp_f32 v60, v60
    v_exp_f32 v61, v61
    v_exp_f32 v62, v62
    v_exp_f32 v63, v63
    v_smfmac_f32_32x32x32_bf16 v[84:99], v[36:39], v[52:59], v6
    ds_read_b128 v[28:31], v3 offset:20480
    v_exp_f32 v64, v64
    v_exp_f32 v65, v65
    v_exp_f32 v66, v66
    v_exp_f32 v67, v67
    v_exp_f32 v68, v68
    v_exp_f32 v69, v69
    v_smfmac_f32_32x32x32_bf16 v[84:99], v[44:47], v[60:67], v6
    ds_read_b64_tr_b16 v[48:49], v4 offset:3584
    v_exp_f32 v70, v70
    v_exp_f32 v71, v71
    v_exp_f32 v72, v72
    v_exp_f32 v73, v73
    v_exp_f32 v74, v74
    v_mfma_f32_32x32x16_bf16 v[52:67], v[32:35], v[20:23], 0
    ds_read_b64_tr_b16 v[50:51], v4 offset:3712
    v_exp_f32 v75, v75
    v_exp_f32 v76, v76
    v_exp_f32 v77, v77
    v_exp_f32 v78, v78
    v_exp_f32 v79, v79
    v_smfmac_f32_32x32x32_bf16 v[100:115], v[36:39], v[68:75], v6
    s_waitcnt lgkmcnt(0)
    v_exp_f32 v80, v80
    v_exp_f32 v81, v81
    v_exp_f32 v82, v82
    v_exp_f32 v83, v83
    v_exp_f32 v52, v52
    v_exp_f32 v53, v53
    v_smfmac_f32_32x32x32_bf16 v[100:115], v[44:47], v[76:83], v6
    ds_read_b64_tr_b16 v[36:37], v4 offset:4096
    v_exp_f32 v54, v54
    v_exp_f32 v55, v55
    v_exp_f32 v56, v56
    v_exp_f32 v57, v57
    v_exp_f32 v58, v58
    v_mfma_f32_32x32x16_bf16 v[68:83], v[32:35], v[24:27], 0
    ds_read_b64_tr_b16 v[38:39], v4 offset:4224
    v_exp_f32 v59, v59
    v_exp_f32 v60, v60
    v_exp_f32 v61, v61
    v_exp_f32 v62, v62
    v_exp_f32 v63, v63
    v_smfmac_f32_32x32x32_bf16 v[84:99], v[40:43], v[52:59], v6
    ds_read_b128 v[32:35], v3 offset:21504
    v_exp_f32 v64, v64
    v_exp_f32 v65, v65
    v_exp_f32 v66, v66
    v_exp_f32 v67, v67
    v_exp_f32 v68, v68
    v_exp_f32 v69, v69
    v_smfmac_f32_32x32x32_bf16 v[84:99], v[48:51], v[60:67], v6
    ds_read_b64_tr_b16 v[44:45], v4 offset:4608
    v_exp_f32 v70, v70
    v_exp_f32 v71, v71
    v_exp_f32 v72, v72
    v_exp_f32 v73, v73
    v_exp_f32 v74, v74
    v_mfma_f32_32x32x16_bf16 v[52:67], v[28:31], v[20:23], 0
    ds_read_b64_tr_b16 v[46:47], v4 offset:4736
    v_exp_f32 v75, v75
    v_exp_f32 v76, v76
    v_exp_f32 v77, v77
    v_exp_f32 v78, v78
    v_exp_f32 v79, v79
    v_smfmac_f32_32x32x32_bf16 v[100:115], v[40:43], v[68:75], v6
    s_waitcnt lgkmcnt(0)
    v_add_u32 v4, v5, v4
    v_exp_f32 v80, v80
    v_exp_f32 v81, v81
    v_exp_f32 v82, v82
    v_exp_f32 v83, v83
    v_exp_f32 v52, v52
    v_exp_f32 v53, v53
    v_smfmac_f32_32x32x32_bf16 v[100:115], v[48:51], v[76:83], v6
    ds_read_b64_tr_b16 v[40:41], v4 offset:1024
    v_exp_f32 v54, v54
    v_exp_f32 v55, v55
    v_exp_f32 v56, v56
    v_exp_f32 v57, v57
    v_exp_f32 v58, v58
    v_mfma_f32_32x32x16_bf16 v[68:83], v[28:31], v[24:27], 0
    ds_read_b64_tr_b16 v[42:43], v4 offset:1152
    v_exp_f32 v59, v59
    v_exp_f32 v60, v60
    v_exp_f32 v61, v61
    v_exp_f32 v62, v62
    v_exp_f32 v63, v63
    v_smfmac_f32_32x32x32_bf16 v[84:99], v[36:39], v[52:59], v6
    ds_read_b128 v[28:31], v3 offset:22528
    v_exp_f32 v64, v64
    v_exp_f32 v65, v65
    v_exp_f32 v66, v66
    v_exp_f32 v67, v67
    v_exp_f32 v68, v68
    v_exp_f32 v69, v69
    v_smfmac_f32_32x32x32_bf16 v[84:99], v[44:47], v[60:67], v6
    ds_read_b64_tr_b16 v[48:49], v4 offset:1536
    v_exp_f32 v70, v70
    v_exp_f32 v71, v71
    v_exp_f32 v72, v72
    v_exp_f32 v73, v73
    v_exp_f32 v74, v74
    v_mfma_f32_32x32x16_bf16 v[52:67], v[32:35], v[20:23], 0
    ds_read_b64_tr_b16 v[50:51], v4 offset:1664
    v_exp_f32 v75, v75
    v_exp_f32 v76, v76
    v_exp_f32 v77, v77
    v_exp_f32 v78, v78
    v_exp_f32 v79, v79
    v_smfmac_f32_32x32x32_bf16 v[100:115], v[36:39], v[68:75], v6
    s_waitcnt lgkmcnt(0)
    v_exp_f32 v80, v80
    v_exp_f32 v81, v81
    v_exp_f32 v82, v82
    v_exp_f32 v83, v83
    v_exp_f32 v52, v52
    v_exp_f32 v53, v53
    v_smfmac_f32_32x32x32_bf16 v[100:115], v[44:47], v[76:83], v6
    ds_read_b64_tr_b16 v[36:37], v4 offset:2048
    v_exp_f32 v54, v54
    v_exp_f32 v55, v55
    v_exp_f32 v56, v56
    v_exp_f32 v57, v57
    v_exp_f32 v58, v58
    v_mfma_f32_32x32x16_bf16 v[68:83], v[32:35], v[24:27], 0
    ds_read_b64_tr_b16 v[38:39], v4 offset:2176
    v_exp_f32 v59, v59
    v_exp_f32 v60, v60
    v_exp_f32 v61, v61
    v_exp_f32 v62, v62
    v_exp_f32 v63, v63
    v_smfmac_f32_32x32x32_bf16 v[84:99], v[40:43], v[52:59], v6
    ds_read_b128 v[32:35], v3 offset:23552
    v_exp_f32 v64, v64
    v_exp_f32 v65, v65
    v_exp_f32 v66, v66
    v_exp_f32 v67, v67
    v_exp_f32 v68, v68
    v_exp_f32 v69, v69
    v_smfmac_f32_32x32x32_bf16 v[84:99], v[48:51], v[60:67], v6
    ds_read_b64_tr_b16 v[44:45], v4 offset:2560
    v_exp_f32 v70, v70
    v_exp_f32 v71, v71
    v_exp_f32 v72, v72
    v_exp_f32 v73, v73
    v_exp_f32 v74, v74
    v_mfma_f32_32x32x16_bf16 v[52:67], v[28:31], v[20:23], 0
    ds_read_b64_tr_b16 v[46:47], v4 offset:2688
    v_exp_f32 v75, v75
    v_exp_f32 v76, v76
    v_exp_f32 v77, v77
    v_exp_f32 v78, v78
    v_exp_f32 v79, v79
    v_smfmac_f32_32x32x32_bf16 v[100:115], v[40:43], v[68:75], v6
    s_waitcnt lgkmcnt(0)
    v_exp_f32 v80, v80
    v_exp_f32 v81, v81
    v_exp_f32 v82, v82
    v_exp_f32 v83, v83
    v_exp_f32 v52, v52
    v_exp_f32 v53, v53
    v_smfmac_f32_32x32x32_bf16 v[100:115], v[48:51], v[76:83], v6
    ds_read_b64_tr_b16 v[40:41], v4 offset:3072
    v_exp_f32 v54, v54
    v_exp_f32 v55, v55
    v_exp_f32 v56, v56
    v_exp_f32 v57, v57
    v_exp_f32 v58, v58
    v_mfma_f32_32x32x16_bf16 v[68:83], v[28:31], v[24:27], 0
    ds_read_b64_tr_b16 v[42:43], v4 offset:3200
    v_exp_f32 v59, v59
    v_exp_f32 v60, v60
    v_exp_f32 v61, v61
    v_exp_f32 v62, v62
    v_exp_f32 v63, v63
    v_smfmac_f32_32x32x32_bf16 v[84:99], v[36:39], v[52:59], v6
    ds_read_b128 v[28:31], v3 offset:24576
    v_exp_f32 v64, v64
    v_exp_f32 v65, v65
    v_exp_f32 v66, v66
    v_exp_f32 v67, v67
    v_exp_f32 v68, v68
    v_exp_f32 v69, v69
    v_smfmac_f32_32x32x32_bf16 v[84:99], v[44:47], v[60:67], v6
    ds_read_b64_tr_b16 v[48:49], v4 offset:3584
    v_exp_f32 v70, v70
    v_exp_f32 v71, v71
    v_exp_f32 v72, v72
    v_exp_f32 v73, v73
    v_exp_f32 v74, v74
    v_mfma_f32_32x32x16_bf16 v[52:67], v[32:35], v[20:23], 0
    ds_read_b64_tr_b16 v[50:51], v4 offset:3712
    v_exp_f32 v75, v75
    v_exp_f32 v76, v76
    v_exp_f32 v77, v77
    v_exp_f32 v78, v78
    v_exp_f32 v79, v79
    v_smfmac_f32_32x32x32_bf16 v[100:115], v[36:39], v[68:75], v6
    s_waitcnt lgkmcnt(0)
    v_exp_f32 v80, v80
    v_exp_f32 v81, v81
    v_exp_f32 v82, v82
    v_exp_f32 v83, v83
    v_exp_f32 v52, v52
    v_exp_f32 v53, v53
    v_smfmac_f32_32x32x32_bf16 v[100:115], v[44:47], v[76:83], v6
    ds_read_b64_tr_b16 v[36:37], v4 offset:4096
    v_exp_f32 v54, v54
    v_exp_f32 v55, v55
    v_exp_f32 v56, v56
    v_exp_f32 v57, v57
    v_exp_f32 v58, v58
    v_mfma_f32_32x32x16_bf16 v[68:83], v[32:35], v[24:27], 0
    ds_read_b64_tr_b16 v[38:39], v4 offset:4224
    v_exp_f32 v59, v59
    v_exp_f32 v60, v60
    v_exp_f32 v61, v61
    v_exp_f32 v62, v62
    v_exp_f32 v63, v63
    v_smfmac_f32_32x32x32_bf16 v[84:99], v[40:43], v[52:59], v6
    ds_read_b128 v[32:35], v3 offset:25600
    v_exp_f32 v64, v64
    v_exp_f32 v65, v65
    v_exp_f32 v66, v66
    v_exp_f32 v67, v67
    v_exp_f32 v68, v68
    v_exp_f32 v69, v69
    v_smfmac_f32_32x32x32_bf16 v[84:99], v[48:51], v[60:67], v6
    ds_read_b64_tr_b16 v[44:45], v4 offset:4608
    v_exp_f32 v70, v70
    v_exp_f32 v71, v71
    v_exp_f32 v72, v72
    v_exp_f32 v73, v73
    v_exp_f32 v74, v74
    v_mfma_f32_32x32x16_bf16 v[52:67], v[28:31], v[20:23], 0
    ds_read_b64_tr_b16 v[46:47], v4 offset:4736
    v_exp_f32 v75, v75
    v_exp_f32 v76, v76
    v_exp_f32 v77, v77
    v_exp_f32 v78, v78
    v_exp_f32 v79, v79
    v_smfmac_f32_32x32x32_bf16 v[100:115], v[40:43], v[68:75], v6
    s_waitcnt lgkmcnt(0)
    v_add_u32 v4, v5, v4
    v_exp_f32 v80, v80
    v_exp_f32 v81, v81
    v_exp_f32 v82, v82
    v_exp_f32 v83, v83
    v_exp_f32 v52, v52
    v_exp_f32 v53, v53
    v_smfmac_f32_32x32x32_bf16 v[100:115], v[48:51], v[76:83], v6
    ds_read_b64_tr_b16 v[40:41], v4 offset:1024
    v_exp_f32 v54, v54
    v_exp_f32 v55, v55
    v_exp_f32 v56, v56
    v_exp_f32 v57, v57
    v_exp_f32 v58, v58
    v_mfma_f32_32x32x16_bf16 v[68:83], v[28:31], v[24:27], 0
    ds_read_b64_tr_b16 v[42:43], v4 offset:1152
    v_exp_f32 v59, v59
    v_exp_f32 v60, v60
    v_exp_f32 v61, v61
    v_exp_f32 v62, v62
    v_exp_f32 v63, v63
    v_smfmac_f32_32x32x32_bf16 v[84:99], v[36:39], v[52:59], v6
    ds_read_b128 v[28:31], v3 offset:26624
    v_exp_f32 v64, v64
    v_exp_f32 v65, v65
    v_exp_f32 v66, v66
    v_exp_f32 v67, v67
    v_exp_f32 v68, v68
    v_exp_f32 v69, v69
    v_smfmac_f32_32x32x32_bf16 v[84:99], v[44:47], v[60:67], v6
    ds_read_b64_tr_b16 v[48:49], v4 offset:1536
    v_exp_f32 v70, v70
    v_exp_f32 v71, v71
    v_exp_f32 v72, v72
    v_exp_f32 v73, v73
    v_exp_f32 v74, v74
    v_mfma_f32_32x32x16_bf16 v[52:67], v[32:35], v[20:23], 0
    ds_read_b64_tr_b16 v[50:51], v4 offset:1664
    v_exp_f32 v75, v75
    v_exp_f32 v76, v76
    v_exp_f32 v77, v77
    v_exp_f32 v78, v78
    v_exp_f32 v79, v79
    v_smfmac_f32_32x32x32_bf16 v[100:115], v[36:39], v[68:75], v6
    s_waitcnt lgkmcnt(0)
    v_exp_f32 v80, v80
    v_exp_f32 v81, v81
    v_exp_f32 v82, v82
    v_exp_f32 v83, v83
    v_exp_f32 v52, v52
    v_exp_f32 v53, v53
    v_smfmac_f32_32x32x32_bf16 v[100:115], v[44:47], v[76:83], v6
    ds_read_b64_tr_b16 v[36:37], v4 offset:2048
    v_exp_f32 v54, v54
    v_exp_f32 v55, v55
    v_exp_f32 v56, v56
    v_exp_f32 v57, v57
    v_exp_f32 v58, v58
    v_mfma_f32_32x32x16_bf16 v[68:83], v[32:35], v[24:27], 0
    ds_read_b64_tr_b16 v[38:39], v4 offset:2176
    v_exp_f32 v59, v59
    v_exp_f32 v60, v60
    v_exp_f32 v61, v61
    v_exp_f32 v62, v62
    v_exp_f32 v63, v63
    v_smfmac_f32_32x32x32_bf16 v[84:99], v[40:43], v[52:59], v6
    ds_read_b128 v[32:35], v3 offset:27648
    v_exp_f32 v64, v64
    v_exp_f32 v65, v65
    v_exp_f32 v66, v66
    v_exp_f32 v67, v67
    v_exp_f32 v68, v68
    v_exp_f32 v69, v69
    v_smfmac_f32_32x32x32_bf16 v[84:99], v[48:51], v[60:67], v6
    ds_read_b64_tr_b16 v[44:45], v4 offset:2560
    v_exp_f32 v70, v70
    v_exp_f32 v71, v71
    v_exp_f32 v72, v72
    v_exp_f32 v73, v73
    v_exp_f32 v74, v74
    v_mfma_f32_32x32x16_bf16 v[52:67], v[28:31], v[20:23], 0
    ds_read_b64_tr_b16 v[46:47], v4 offset:2688
    v_exp_f32 v75, v75
    v_exp_f32 v76, v76
    v_exp_f32 v77, v77
    v_exp_f32 v78, v78
    v_exp_f32 v79, v79
    v_smfmac_f32_32x32x32_bf16 v[100:115], v[40:43], v[68:75], v6
    s_waitcnt lgkmcnt(0)
    v_exp_f32 v80, v80
    v_exp_f32 v81, v81
    v_exp_f32 v82, v82
    v_exp_f32 v83, v83
    v_exp_f32 v52, v52
    v_exp_f32 v53, v53
    v_smfmac_f32_32x32x32_bf16 v[100:115], v[48:51], v[76:83], v6
    ds_read_b64_tr_b16 v[40:41], v4 offset:3072
    v_exp_f32 v54, v54
    v_exp_f32 v55, v55
    v_exp_f32 v56, v56
    v_exp_f32 v57, v57
    v_exp_f32 v58, v58
    v_mfma_f32_32x32x16_bf16 v[68:83], v[28:31], v[24:27], 0
    ds_read_b64_tr_b16 v[42:43], v4 offset:3200
    v_exp_f32 v59, v59
    v_exp_f32 v60, v60
    v_exp_f32 v61, v61
    v_exp_f32 v62, v62
    v_exp_f32 v63, v63
    v_smfmac_f32_32x32x32_bf16 v[84:99], v[36:39], v[52:59], v6
    ds_read_b128 v[28:31], v3 offset:28672
    v_exp_f32 v64, v64
    v_exp_f32 v65, v65
    v_exp_f32 v66, v66
    v_exp_f32 v67, v67
    v_exp_f32 v68, v68
    v_exp_f32 v69, v69
    v_smfmac_f32_32x32x32_bf16 v[84:99], v[44:47], v[60:67], v6
    ds_read_b64_tr_b16 v[48:49], v4 offset:3584
    v_exp_f32 v70, v70
    v_exp_f32 v71, v71
    v_exp_f32 v72, v72
    v_exp_f32 v73, v73
    v_exp_f32 v74, v74
    v_mfma_f32_32x32x16_bf16 v[52:67], v[32:35], v[20:23], 0
    ds_read_b64_tr_b16 v[50:51], v4 offset:3712
    v_exp_f32 v75, v75
    v_exp_f32 v76, v76
    v_exp_f32 v77, v77
    v_exp_f32 v78, v78
    v_exp_f32 v79, v79
    v_smfmac_f32_32x32x32_bf16 v[100:115], v[36:39], v[68:75], v6
    s_waitcnt lgkmcnt(0)
    v_exp_f32 v80, v80
    v_exp_f32 v81, v81
    v_exp_f32 v82, v82
    v_exp_f32 v83, v83
    v_exp_f32 v52, v52
    v_exp_f32 v53, v53
    v_smfmac_f32_32x32x32_bf16 v[100:115], v[44:47], v[76:83], v6
    ds_read_b64_tr_b16 v[36:37], v4 offset:4096
    v_exp_f32 v54, v54
    v_exp_f32 v55, v55
    v_exp_f32 v56, v56
    v_exp_f32 v57, v57
    v_exp_f32 v58, v58
    v_mfma_f32_32x32x16_bf16 v[68:83], v[32:35], v[24:27], 0
    ds_read_b64_tr_b16 v[38:39], v4 offset:4224
    v_exp_f32 v59, v59
    v_exp_f32 v60, v60
    v_exp_f32 v61, v61
    v_exp_f32 v62, v62
    v_exp_f32 v63, v63
    v_smfmac_f32_32x32x32_bf16 v[84:99], v[40:43], v[52:59], v6
    ds_read_b128 v[32:35], v3 offset:29696
    v_exp_f32 v64, v64
    v_exp_f32 v65, v65
    v_exp_f32 v66, v66
    v_exp_f32 v67, v67
    v_exp_f32 v68, v68
    v_exp_f32 v69, v69
    v_smfmac_f32_32x32x32_bf16 v[84:99], v[48:51], v[60:67], v6
    ds_read_b64_tr_b16 v[44:45], v4 offset:4608
    v_exp_f32 v70, v70
    v_exp_f32 v71, v71
    v_exp_f32 v72, v72
    v_exp_f32 v73, v73
    v_exp_f32 v74, v74
    v_mfma_f32_32x32x16_bf16 v[52:67], v[28:31], v[20:23], 0
    ds_read_b64_tr_b16 v[46:47], v4 offset:4736
    v_exp_f32 v75, v75
    v_exp_f32 v76, v76
    v_exp_f32 v77, v77
    v_exp_f32 v78, v78
    v_exp_f32 v79, v79
    v_smfmac_f32_32x32x32_bf16 v[100:115], v[40:43], v[68:75], v6
    s_waitcnt lgkmcnt(0)
    v_add_u32 v4, v5, v4
    v_exp_f32 v80, v80
    v_exp_f32 v81, v81
    v_exp_f32 v82, v82
    v_exp_f32 v83, v83
    v_exp_f32 v52, v52
    v_exp_f32 v53, v53
    v_smfmac_f32_32x32x32_bf16 v[100:115], v[48:51], v[76:83], v6
    ds_read_b64_tr_b16 v[40:41], v4 offset:1024
    v_exp_f32 v54, v54
    v_exp_f32 v55, v55
    v_exp_f32 v56, v56
    v_exp_f32 v57, v57
    v_exp_f32 v58, v58
    v_mfma_f32_32x32x16_bf16 v[68:83], v[28:31], v[24:27], 0
    ds_read_b64_tr_b16 v[42:43], v4 offset:1152
    v_exp_f32 v59, v59
    v_exp_f32 v60, v60
    v_exp_f32 v61, v61
    v_exp_f32 v62, v62
    v_exp_f32 v63, v63
    v_smfmac_f32_32x32x32_bf16 v[84:99], v[36:39], v[52:59], v6
    ds_read_b128 v[28:31], v3 offset:30720
    s_setprio 0
    v_exp_f32 v64, v64
    v_exp_f32 v65, v65
    v_exp_f32 v66, v66
    v_exp_f32 v67, v67
    v_exp_f32 v68, v68
    v_exp_f32 v69, v69
    v_smfmac_f32_32x32x32_bf16 v[84:99], v[44:47], v[60:67], v6
    ds_read_b64_tr_b16 v[48:49], v4 offset:1536
    v_exp_f32 v70, v70
    v_exp_f32 v71, v71
    v_exp_f32 v72, v72
    v_exp_f32 v73, v73
    v_exp_f32 v74, v74
    v_mfma_f32_32x32x16_bf16 v[52:67], v[32:35], v[20:23], 0
    ds_read_b64_tr_b16 v[50:51], v4 offset:1664
    v_exp_f32 v75, v75
    v_exp_f32 v76, v76
    v_exp_f32 v77, v77
    v_exp_f32 v78, v78
    v_exp_f32 v79, v79
    v_smfmac_f32_32x32x32_bf16 v[100:115], v[36:39], v[68:75], v6
    s_waitcnt lgkmcnt(0)
    v_exp_f32 v80, v80
    v_exp_f32 v81, v81
    v_exp_f32 v82, v82
    v_exp_f32 v83, v83
    v_exp_f32 v52, v52
    v_exp_f32 v53, v53
    v_smfmac_f32_32x32x32_bf16 v[100:115], v[44:47], v[76:83], v6
    ds_read_b64_tr_b16 v[36:37], v4 offset:2048
    v_exp_f32 v54, v54
    v_exp_f32 v55, v55
    v_exp_f32 v56, v56
    v_exp_f32 v57, v57
    v_exp_f32 v58, v58
    v_mfma_f32_32x32x16_bf16 v[68:83], v[32:35], v[24:27], 0
    ds_read_b64_tr_b16 v[38:39], v4 offset:2176
    v_exp_f32 v59, v59
    v_exp_f32 v60, v60
    v_exp_f32 v61, v61
    v_exp_f32 v62, v62
    v_exp_f32 v63, v63
    v_smfmac_f32_32x32x32_bf16 v[84:99], v[40:43], v[52:59], v6
    ds_read_b128 v[32:35], v3 offset:31744
    v_exp_f32 v64, v64
    v_exp_f32 v65, v65
    v_exp_f32 v66, v66
    v_exp_f32 v67, v67
    v_exp_f32 v68, v68
    v_exp_f32 v69, v69
    v_smfmac_f32_32x32x32_bf16 v[84:99], v[48:51], v[60:67], v6
    ds_read_b64_tr_b16 v[44:45], v4 offset:2560
    v_exp_f32 v70, v70
    v_exp_f32 v71, v71
    v_exp_f32 v72, v72
    v_exp_f32 v73, v73
    v_exp_f32 v74, v74
    v_mfma_f32_32x32x16_bf16 v[52:67], v[28:31], v[20:23], 0
    ds_read_b64_tr_b16 v[46:47], v4 offset:2688
    v_exp_f32 v75, v75
    v_exp_f32 v76, v76
    v_exp_f32 v77, v77
    v_exp_f32 v78, v78
    v_exp_f32 v79, v79
    v_smfmac_f32_32x32x32_bf16 v[100:115], v[40:43], v[68:75], v6
    s_waitcnt lgkmcnt(0)
    v_exp_f32 v80, v80
    v_exp_f32 v81, v81
    v_exp_f32 v82, v82
    v_exp_f32 v83, v83
    v_exp_f32 v52, v52
    v_exp_f32 v53, v53
    v_smfmac_f32_32x32x32_bf16 v[100:115], v[48:51], v[76:83], v6
    ds_read_b64_tr_b16 v[40:41], v4 offset:3072
    v_exp_f32 v54, v54
    v_exp_f32 v55, v55
    v_exp_f32 v56, v56
    v_exp_f32 v57, v57
    v_exp_f32 v58, v58
    v_mfma_f32_32x32x16_bf16 v[68:83], v[32:35], v[20:23], 0
    ds_read_b64_tr_b16 v[42:43], v4 offset:3200
    v_exp_f32 v59, v59
    v_exp_f32 v60, v60
    v_exp_f32 v61, v61
    v_exp_f32 v62, v62
    v_exp_f32 v63, v63
    v_smfmac_f32_32x32x32_bf16 v[84:99], v[36:39], v[52:59], v6
    ds_read_b64_tr_b16 v[48:49], v4 offset:3584
    v_exp_f32 v64, v64
    v_exp_f32 v65, v65
    v_exp_f32 v66, v66
    v_exp_f32 v67, v67
    v_exp_f32 v68, v68
    v_exp_f32 v69, v69
    v_smfmac_f32_32x32x32_bf16 v[84:99], v[44:47], v[60:67], v6
    ds_read_b64_tr_b16 v[50:51], v4 offset:3712
    v_exp_f32 v70, v70
    v_exp_f32 v71, v71
    v_exp_f32 v72, v72
    v_exp_f32 v73, v73
    v_exp_f32 v74, v74
    v_mfma_f32_32x32x16_bf16 v[52:67], v[28:31], v[24:27], 0
    s_waitcnt lgkmcnt(0)
    v_exp_f32 v75, v75
    v_exp_f32 v76, v76
    v_exp_f32 v77, v77
    v_exp_f32 v78, v78
    v_exp_f32 v79, v79
    v_smfmac_f32_32x32x32_bf16 v[84:99], v[40:43], v[68:75], v6
    s_nop 0
    v_exp_f32 v80, v80
    v_exp_f32 v81, v81
    v_exp_f32 v82, v82
    v_exp_f32 v83, v83
    v_exp_f32 v52, v52
    v_exp_f32 v53, v53
    v_smfmac_f32_32x32x32_bf16 v[84:99], v[48:51], v[76:83], v6
    v_exp_f32 v54, v54
    v_exp_f32 v55, v55
    v_exp_f32 v56, v56
    v_exp_f32 v57, v57
    v_exp_f32 v58, v58
    v_mfma_f32_32x32x16_bf16 v[68:83], v[32:35], v[24:27], 0
    v_exp_f32 v59, v59
    v_exp_f32 v60, v60
    v_exp_f32 v61, v61
    v_exp_f32 v62, v62
    v_exp_f32 v63, v63
    v_smfmac_f32_32x32x32_bf16 v[100:115], v[36:39], v[52:59], v6
    ds_write_b128 v7, v[84:87]
    ds_write_b128 v7, v[88:91] offset:1024
    ds_write_b32 v8, v92 offset:2048
    v_exp_f32 v64, v64
    v_exp_f32 v65, v65
    v_exp_f32 v66, v66
    v_exp_f32 v67, v67
    v_exp_f32 v68, v68
    v_exp_f32 v69, v69
    v_smfmac_f32_32x32x32_bf16 v[100:115], v[44:47], v[60:67], v6
    s_waitcnt lgkmcnt(0)
    s_barrier
    ds_read_b128 v[116:119], v9
    ds_read_b128 v[120:123], v9 offset:1024
    ds_read_b32 v124, v10 offset:2048
    v_exp_f32 v70, v70
    v_exp_f32 v71, v71
    v_exp_f32 v72, v72
    v_exp_f32 v73, v73
    v_exp_f32 v74, v74
    v_exp_f32 v75, v75
    v_exp_f32 v76, v76
    v_exp_f32 v77, v77
    v_exp_f32 v78, v78
    v_exp_f32 v79, v79
    v_smfmac_f32_32x32x32_bf16 v[100:115], v[40:43], v[68:75], v6
    v_exp_f32 v80, v80
    v_exp_f32 v81, v81
    v_exp_f32 v82, v82
    v_exp_f32 v83, v83
    s_waitcnt lgkmcnt(0)
    s_nop 0
    v_smfmac_f32_32x32x32_bf16 v[100:115], v[48:51], v[76:83], v6
    s_nop 11
    v_add_f32 v108, v108, v124
    v_pk_add_f32 v[100:101], v[100:101], v[116:117]
    v_rcp_f32 v12, v108
    v_pk_add_f32 v[102:103], v[102:103], v[118:119]
    v_pk_add_f32 v[104:105], v[104:105], v[120:121]
    v_pk_add_f32 v[106:107], v[106:107], v[122:123]
    v_pk_mul_f32 v[100:101], v[100:101], v[12:13] op_sel_hi:[1,0]
    v_pk_mul_f32 v[102:103], v[102:103], v[12:13] op_sel_hi:[1,0]
    v_pk_mul_f32 v[104:105], v[104:105], v[12:13] op_sel_hi:[1,0]
    v_pk_mul_f32 v[106:107], v[106:107], v[12:13] op_sel_hi:[1,0]
    v_cvt_pk_bf16_f32 v132, v100, v101
    v_cvt_pk_bf16_f32 v134, v104, v105
    v_cvt_pk_bf16_f32 v133, v102, v103
    v_cvt_pk_bf16_f32 v135, v106, v107
    s_nop 0
    v_permlane32_swap_b32 v132, v134
    v_permlane32_swap_b32 v133, v135
    buffer_store_dwordx4 v[132:135], v1, s[16:19], s26 offen nt
    v_cmp_le_f32 vcc, 1.0, v108
    v_pk_add_f32 v[100:101], v[100:101], v[102:103]
    s_mov_b64 s[30:31], vcc
    v_cmp_ge_f32 vcc, 0x67800000, v108
    v_pk_add_f32 v[104:105], v[104:105], v[106:107]
    v_mov_b32 v16, 0x1f8
    s_and_b64 s[30:31], s[30:31], vcc
    v_pk_add_f32 v[100:101], v[100:101], v[104:105]
    v_add_f32 v100, v100, v101
    v_cmp_class_f32 vcc, v100, v16
    s_and_b64 s[30:31], s[30:31], vcc
    s_cmp_eq_u64 s[30:31], exec
    s_cbranch_scc0 L_slow
L_end:
    s_endpgm
L_slow:
    s_waitcnt vmcnt(0)
    v_add_u32 v3, 8192, v2
    v_mov_b32 v12, 0xff800000
    s_mov_b32 s32, 64
L_s1:
    ds_read_b128 v[28:31], v3 offset:0
    s_waitcnt lgkmcnt(0)
    v_mfma_f32_32x32x16_bf16 v[52:67], v[28:31], v[24:27], 0
    v_add_u32 v3, 0x400, v3
    s_nop 15
    v_max3_f32 v12, v12, v52, v53
    v_max3_f32 v12, v12, v54, v55
    v_max3_f32 v12, v12, v56, v57
    v_max3_f32 v12, v12, v58, v59
    v_max3_f32 v12, v12, v60, v61
    v_max3_f32 v12, v12, v62, v63
    v_max3_f32 v12, v12, v64, v65
    v_max3_f32 v12, v12, v66, v67
    s_sub_u32 s32, s32, 1
    s_cmp_lg_u32 s32, 0
    s_cbranch_scc1 L_s1
    v_mov_b32 v13, v12
    s_nop 1
    v_permlane32_swap_b32 v12, v13
    s_nop 1
    v_max_f32 v12, v12, v13
    v_sub_f32 v116, 0, v12
    v_sub_f32 v117, 0, v12
    v_sub_f32 v118, 0, v12
    v_sub_f32 v119, 0, v12
    v_sub_f32 v120, 0, v12
    v_sub_f32 v121, 0, v12
    v_sub_f32 v122, 0, v12
    v_sub_f32 v123, 0, v12
    v_sub_f32 v124, 0, v12
    v_sub_f32 v125, 0, v12
    v_sub_f32 v126, 0, v12
    v_sub_f32 v127, 0, v12
    v_sub_f32 v128, 0, v12
    v_sub_f32 v129, 0, v12
    v_sub_f32 v130, 0, v12
    v_sub_f32 v131, 0, v12
    v_mov_b32 v100, 0
    v_mov_b32 v101, 0
    v_mov_b32 v102, 0
    v_mov_b32 v103, 0
    v_mov_b32 v104, 0
    v_mov_b32 v105, 0
    v_mov_b32 v106, 0
    v_mov_b32 v107, 0
    v_mov_b32 v108, 0
    v_mov_b32 v109, 0
    v_mov_b32 v110, 0
    v_mov_b32 v111, 0
    v_mov_b32 v112, 0
    v_mov_b32 v113, 0
    v_mov_b32 v114, 0
    v_mov_b32 v115, 0
    v_add_u32 v3, 8192, v2
    v_and_b32 v12, 15, v0
    v_lshlrev_b32 v12, 3, v12
    v_bfe_u32 v13, v0, 5, 1
    v_lshlrev_b32 v13, 8, v13
    v_add_u32 v13, 73728, v13
    v_mov_b32 v14, 128
    v_cmp_ne_u32 vcc, 0, v5
    v_mov_b32 v15, 0x400
    s_nop 0
    v_cndmask_b32 v13, v14, v13, vcc
    v_cndmask_b32 v5, 0, v15, vcc
    v_add_u32 v4, v12, v13
    s_mov_b32 s32, 64
L_s2:
    ds_read_b128 v[28:31], v3 offset:0
    ds_read_b64_tr_b16 v[36:37], v4 offset:0
    ds_read_b64_tr_b16 v[38:39], v4 offset:128
    ds_read_b64_tr_b16 v[44:45], v4 offset:512
    ds_read_b64_tr_b16 v[46:47], v4 offset:640
    s_waitcnt lgkmcnt(0)
    v_mfma_f32_32x32x16_bf16 v[52:67], v[28:31], v[24:27], v[116:131]
    v_add_u32 v3, 0x400, v3
    v_add_u32 v4, v5, v4
    s_nop 15
    v_exp_f32 v52, v52
    v_exp_f32 v53, v53
    v_exp_f32 v54, v54
    v_exp_f32 v55, v55
    v_exp_f32 v56, v56
    v_exp_f32 v57, v57
    v_exp_f32 v58, v58
    v_exp_f32 v59, v59
    v_exp_f32 v60, v60
    v_exp_f32 v61, v61
    v_exp_f32 v62, v62
    v_exp_f32 v63, v63
    v_exp_f32 v64, v64
    v_exp_f32 v65, v65
    v_exp_f32 v66, v66
    v_exp_f32 v67, v67
    s_nop 1
    v_smfmac_f32_32x32x32_bf16 v[100:115], v[36:39], v[52:59], v6
    v_smfmac_f32_32x32x32_bf16 v[100:115], v[44:47], v[60:67], v6
    s_sub_u32 s32, s32, 1
    s_cmp_lg_u32 s32, 0
    s_cbranch_scc1 L_s2
    s_nop 15
    v_rcp_f32 v12, v108
    s_nop 0
    v_pk_mul_f32 v[100:101], v[100:101], v[12:13] op_sel_hi:[1,0]
    v_pk_mul_f32 v[102:103], v[102:103], v[12:13] op_sel_hi:[1,0]
    v_pk_mul_f32 v[104:105], v[104:105], v[12:13] op_sel_hi:[1,0]
    v_pk_mul_f32 v[106:107], v[106:107], v[12:13] op_sel_hi:[1,0]
    v_cvt_pk_bf16_f32 v132, v100, v101
    v_cvt_pk_bf16_f32 v134, v104, v105
    v_cvt_pk_bf16_f32 v133, v102, v103
    v_cvt_pk_bf16_f32 v135, v106, v107
    s_nop 0
    v_permlane32_swap_b32 v132, v134
    v_permlane32_swap_b32 v133, v135
    buffer_store_dwordx4 v[132:135], v1, s[16:19], s26 offen nt
    s_endpgm
.section .rodata,"a"
.p2align 6
.amdhsa_kernel standalone__fused_io_aware_attn__prompt_kernel
  .amdhsa_next_free_vgpr 138
  .amdhsa_next_free_sgpr 40
  .amdhsa_accum_offset 140
  .amdhsa_group_segment_fixed_size 0
  .amdhsa_kernarg_size 48
  .amdhsa_user_sgpr_count 2
  .amdhsa_user_sgpr_kernarg_segment_ptr 1
  .amdhsa_system_sgpr_workgroup_id_x 1
.end_amdhsa_kernel
```
